```python
import torch

def _softmax(x, axis=-1):
    return torch.softmax(x, dim=axis)
def _gelu(x):
    return torch.nn.functional.gelu(x, approximate="tanh")
def _silu(x):
    return torch.nn.functional.silu(x)
def _sigmoid(x):
    return torch.sigmoid(x)
def _layernorm(x, axis=-1, eps=1e-5):
    m = x.mean(dim=axis, keepdim=True)
    v = x.var(dim=axis, keepdim=True, unbiased=False)
    return (x - m) / torch.sqrt(v + eps)
def _scatter_add(tgt, idx, src, axis=0):
    return tgt.clone().index_add_(axis, idx, src)
def _segment_sum(src, seg, n):
    out = torch.zeros((n,) + src.shape[1:], dtype=src.dtype)
    return out.index_add_(0, seg, src)
def _pad(x, pw):
    flat = tuple(v for pair in reversed(pw) for v in pair)
    return torch.nn.functional.pad(x, flat)

kernel_name = 'gated_mix__sliding_block_cached__dense_activation_relu__decode'

def setup_inputs():

    _w = (lambda a: (lambda t: t.to(torch.bfloat16) if t.is_floating_point() else t)(torch.as_tensor(a)))
    def _A_setup():
        B, Sq, D = 2, 1, 448
        Hq, Hkv, Sk, Dh = 16, 8, 4096, 256
        assert Hq % Hkv == 0, (Hq, Hkv)
        return {
            "x": _w((lambda *s: torch.randn(*s, dtype=torch.bfloat16) * 0.05)(B, Sq, D)),
            "k_cache": _w((lambda *s: torch.randn(*s, dtype=torch.bfloat16) * 6.4)(B, Hkv, Sk, Dh)),
            "v_cache": _w((lambda *s: torch.randn(*s, dtype=torch.bfloat16) * 0.4)(B, Hkv, Sk, Dh)),
            "wq": _w((lambda *s: torch.randn(*s, dtype=torch.bfloat16) * 6.4)(D, Hq * Dh) * (D ** -0.5)),
            "wo": _w((lambda *s: torch.randn(*s, dtype=torch.bfloat16) * 0.4)(Hq * Dh, D) * ((Hq * Dh) ** -0.5)),
        }
    _A_in = _A_setup()

    def _B_setup():
        B, S, D, Dff = 2, 1, 448, 1792
        return {
            "x": _w((lambda *s: torch.randn(*s, dtype=torch.bfloat16) * 0.05)(B, S, D)),
            "w1": _w((lambda *s: torch.randn(*s, dtype=torch.bfloat16) * 0.05)(D, Dff)),
            "w2": _w((lambda *s: torch.randn(*s, dtype=torch.bfloat16) * 0.05)(Dff, D)),
        }
    _B_in = _B_setup()

    return {
        "A_x": _A_in["x"],
        "A_k_cache": _A_in["k_cache"],
        "A_v_cache": _A_in["v_cache"],
        "A_wq": _A_in["wq"],
        "A_wo": _A_in["wo"],
        "B_x": _B_in["x"],
        "B_w1": _B_in["w1"],
        "B_w2": _B_in["w2"],
        "gate_w": _w((lambda *s: torch.randn(*s, dtype=torch.bfloat16) * 0.05)(448) * 16.0),
    }

def reference(A_x, A_k_cache, A_v_cache, A_wq, A_wo, B_x, B_w1, B_w2, gate_w):
    def _A_ref(x, k_cache, v_cache, wq, wo):
        B, Sq, D = x.shape
        Hq, Dh = 16, 256
        Hkv, Sk = k_cache.shape[1], k_cache.shape[2]
        W = min(4096, max(256, Sk // 4))
        rep = Hq // Hkv
        q = (lambda x, *d: x.permute(*d))((x @ wq).reshape(B, Sq, Hq, Dh), 0, 2, 1, 3)
        k = (lambda x, n, axis: torch.repeat_interleave(x, n, dim=axis))(k_cache[:, :, Sk - W:, :], rep, axis=1)
        v = (lambda x, n, axis: torch.repeat_interleave(x, n, dim=axis))(v_cache[:, :, Sk - W:, :], rep, axis=1)
        scores = torch.einsum("bhqd,bhkd->bhqk", q, k) * (Dh ** -0.5)
        p = _softmax(scores, axis=-1)
        o = torch.einsum("bhqk,bhkd->bhqd", p, v)
        return (lambda x, *d: x.permute(*d))(o, 0, 2, 1, 3).reshape(B, Sq, Hq * Dh) @ wo

    def _B_ref(x, w1, w2):
        h = torch.einsum("bsd,df->bsf", x, w1)
        zero = torch.zeros_like(h)
        h = torch.maximum(h, zero)
        return torch.einsum("bsf,fd->bsd", h, w2)

    x = A_x
    g = _sigmoid((x * gate_w).sum(-1, keepdims=True))
    a = _A_ref(x, A_k_cache, A_v_cache, A_wq, A_wo)
    b = _B_ref(x, B_w1, B_w2)
    return g * a + (1 - g) * b
```

```asm
; @launch grid=(256,1,1) block=(320,1,1) lds=120576
.amdgcn_target "amdgcn-amd-amdhsa--gfx950"
.text
.globl gated_mix__sliding_block_cached__dense_activation_relu__decode_kernel
.p2align 8
.type gated_mix__sliding_block_cached__dense_activation_relu__decode_kernel,@function
gated_mix__sliding_block_cached__dense_activation_relu__decode_kernel:

  s_load_dwordx16 s[4:19], s[0:1], 0
  s_load_dwordx8 s[20:27], s[0:1], 64
  s_getpc_b64 s[34:35]
L_pc:
  v_lshlrev_b32 v1, 5, v0
  v_min_u32 v1, L_code_end - L_pc - 4, v1
  s_cmpk_ge_u32 s2, 0x100
  s_cbranch_scc1 L_end
  global_load_dword v3, v1, s[34:35]
  v_lshrrev_b32 v2, 6, v0
  v_and_b32 v5, 63, v0
  v_readfirstlane_b32 s30, v2
  v_lshrrev_b32 v8, 3, v5
  v_bfe_u32 v9, v5, 4, 2
  v_and_b32 v10, 7, v5
  v_lshlrev_b32 v11, 1, v9
  v_xor_b32 v11, v11, v10
  v_lshlrev_b32 v11, 4, v11
  v_lshl_add_u32 v18, v8, 13, v11
  s_and_b32 s28, s2, 7
  s_cmp_eq_u32 s30, 0
  s_cbranch_scc1 L_aux0
  s_lshr_b32 s42, s2, 6
  s_mul_i32 s42, s42, 917504
  s_lshl_b32 s43, s28, 10
  s_add_u32 s42, s42, s43
  s_bfe_u32 s43, s2, 0x30003
  s_lshl_b32 s43, s43, 7
  s_add_u32 s42, s42, s43
  s_sub_u32 s36, s30, 1
  s_lshl_b32 s43, s36, 16
  s_add_u32 s42, s42, s43
  v_add_u32 v18, s42, v18
  s_lshl_b32 s43, s36, 10
  s_add_u32 m0, s43, 65536
  s_lshl_b32 s44, 1, 18
  s_movk_i32 s45, 0x1000
  s_waitcnt lgkmcnt(0)
  global_load_lds_dwordx4 v18, s[10:11] nt
  s_add_u32 m0, m0, s45
  v_add_u32 v18, s44, v18
  global_load_lds_dwordx4 v18, s[10:11] nt
  s_add_u32 m0, m0, s45
  v_add_u32 v18, s44, v18
  global_load_lds_dwordx4 v18, s[10:11] nt
  s_cmp_ge_u32 s36, 2
  s_cbranch_scc1 L_wq_done
  s_add_u32 m0, m0, s45
  v_add_u32 v18, s44, v18
  global_load_lds_dwordx4 v18, s[10:11] nt

L_wq_done:
  s_load_dword s31, s[26:27], 0
  s_lshr_b32 s29, s2, 3
  s_mov_b32 s32, 0xff
  v_lshrrev_b32 v13, 4, v5
  s_and_b32 s37, s36, 1
  s_lshr_b32 s38, s36, 1
  s_lshl_b32 s45, s28, 4
  s_add_u32 s45, s45, s29
  s_sub_u32 s45, s45, 16
  s_lshl_b32 s33, s29, 3
  s_add_u32 s33, s33, s28
  s_add_u32 s33, s33, 128
  s_cmp_lt_u32 s29, 16
  s_cselect_b32 s45, s33, s45
  s_mul_i32 s46, s45, 9363
  s_lshr_b32 s46, s46, 16
  s_mul_i32 s47, s46, 7
  s_sub_u32 s47, s45, s47
  s_min_u32 s46, s46, 27
  s_lshl_b32 s46, s46, 7
  s_mul_i32 s47, s47, 229376
  s_add_u32 s46, s46, s47
  s_mul_i32 s47, s36, 28672
  s_add_u32 s46, s46, s47
  s_cmp_lt_u32 s45, 196
  s_cselect_b32 s45, 0, 0x40000000
  v_mul_u32_u24 v18, 3584, v8
  v_add3_u32 v18, v18, v11, s45
  s_lshl_b32 s47, s36, 10
  s_add_u32 s47, s47, 108544

  s_mov_b32 s52, s16
  s_mov_b32 s53, s17
  s_mov_b32 s54, 1605632
  s_mov_b32 s55, 0x20000
  s_add_u32 m0, s47, 0
  s_add_u32 s45, s46, 0
  buffer_load_dwordx4 v18, s[52:55], s45 offen nt lds
  s_add_u32 m0, s47, 4096
  s_add_u32 s45, s46, 114688
  buffer_load_dwordx4 v18, s[52:55], s45 offen nt lds
  v_xor_b32 v12, v9, v10
  v_lshlrev_b32 v12, 4, v12
  s_and_b32 s39, s29, 1
  s_lshr_b32 s40, s29, 1
  s_lshl_b32 s41, s39, 3
  s_add_u32 s41, s41, s28
  s_lshl_b32 s41, s41, 21
  s_lshl_b32 s42, s40, 15
  s_add_u32 s41, s41, s42
  s_add_u32 s41, s41, 1572864
  s_lshl_b32 s43, s36, 10
  s_add_u32 s57, s41, s43
  s_lshl_b32 s43, s36, 11
  s_lshl_b32 s56, s36, 7
  s_add_u32 s41, s41, s56
  s_lshl_b32 s56, s36, 13
  v_lshlrev_b32 v18, 12, v8
  v_add_u32 v19, v18, v12
  v_xor_b32 v20, 64, v19
  v_add_u32 v21, v18, v11

  s_mov_b32 s44, s6
  s_mov_b32 s45, s7
  s_mov_b32 s46, 33554432
  s_mov_b32 s47, 0x20000
  s_mov_b32 s48, s8
  s_mov_b32 s49, s9
  s_mov_b32 s50, 33554432
  s_mov_b32 s51, 0x20000
  s_add_u32 m0, s43, 0
  s_add_u32 s42, s57, 0
  buffer_load_dwordx4 v19, s[44:47], s42 offen nt lds
  s_add_u32 m0, s43, 1024
  s_add_u32 s42, s57, 512
  buffer_load_dwordx4 v20, s[44:47], s42 offen nt lds
  s_add_u32 m0, s43, 8192
  s_add_u32 s42, s57, 128
  buffer_load_dwordx4 v19, s[44:47], s42 offen nt lds
  s_add_u32 m0, s43, 9216
  s_add_u32 s42, s57, 640
  buffer_load_dwordx4 v20, s[44:47], s42 offen nt lds
  s_add_u32 m0, s43, 16384
  s_add_u32 s42, s57, 256
  buffer_load_dwordx4 v19, s[44:47], s42 offen nt lds
  s_add_u32 m0, s43, 17408
  s_add_u32 s42, s57, 768
  buffer_load_dwordx4 v20, s[44:47], s42 offen nt lds
  s_add_u32 m0, s43, 24576
  s_add_u32 s42, s57, 384
  buffer_load_dwordx4 v19, s[44:47], s42 offen nt lds
  s_add_u32 m0, s43, 25600
  s_add_u32 s42, s57, 896
  buffer_load_dwordx4 v20, s[44:47], s42 offen nt lds
  v_bfe_u32 v14, v5, 2, 2
  v_lshl_add_u32 v15, v13, 2, v14
  v_bfe_u32 v16, v15, 1, 2
  v_and_b32 v17, 3, v5
  v_lshlrev_b32 v15, 7, v15
  v_lshl_add_u32 v15, v17, 3, v15
  v_xor_b32 v24, s36, v16
  v_lshl_add_u32 v24, v24, 5, v15
  v_add_u32 v24, 65536, v24
  v_and_b32 v25, 1, v5
  v_mul_u32_u24 v25, 896, v25
  v_lshl_add_u32 v25, v13, 3, v25
  s_lshr_b32 s42, s29, 3
  s_mul_i32 s45, s42, 224
  s_add_u32 s45, s45, 116736
  v_add_u32 v25, s45, v25
  s_lshl_b32 s45, s28, 14
  s_lshl_b32 s42, s42, 12
  s_add_u32 s45, s45, s42
  s_and_b32 s42, s29, 7
  s_lshl_b32 s42, s42, 8
  s_add_u32 s45, s45, s42
  s_lshl_b32 s42, s36, 6
  s_add_u32 s45, s45, s42
  s_add_u32 s45, s45, 4096
  v_lshlrev_b32 v26, 2, v5
  v_add_u32 v26, s45, v26

  s_waitcnt lgkmcnt(0)
  s_and_b32 s31, s31, 0xff
  s_mul_i32 s31, s31, 5
  s_add_u32 s31, s31, 59
  s_and_b32 s31, s31, 0xff
  v_mov_b32 v4, s31
  s_waitcnt vmcnt(10)
  s_barrier
  ds_read2_b64 v[32:35], v25 offset0:0 offset1:4
  ds_read_b64_tr_b16 v[48:49], v24 offset:0
  ds_read_b64_tr_b16 v[50:51], v24 offset:2048
  ds_read2_b64 v[36:39], v25 offset0:8 offset1:12
  ds_read_b64_tr_b16 v[52:53], v24 offset:4096
  ds_read_b64_tr_b16 v[54:55], v24 offset:6144
  ds_read2_b64 v[40:43], v25 offset0:16 offset1:20
  ds_read_b64_tr_b16 v[56:57], v24 offset:8192
  ds_read_b64_tr_b16 v[58:59], v24 offset:10240
  ds_read_b64 v[44:45], v25 offset:192
  ds_read_b64_tr_b16 v[60:61], v24 offset:12288
  s_waitcnt lgkmcnt(8)
  v_mfma_f32_16x16x32_bf16 v[64:67], v[32:35], v[48:51], 0
  s_waitcnt lgkmcnt(5)
  v_mfma_f32_16x16x32_bf16 v[64:67], v[36:39], v[52:55], v[64:67]
  s_waitcnt lgkmcnt(2)
  v_mfma_f32_16x16x32_bf16 v[64:67], v[40:43], v[56:59], v[64:67]
  s_waitcnt lgkmcnt(0)
  v_mfma_f32_16x16x16_bf16 v[68:71], v[44:45], v[60:61], 0
  s_mov_b64 exec, 0xffff
  s_nop 6
  v_add_f32 v64, v64, v68
  v_add_f32 v65, v65, v69
  v_bfi_b32 v64, s32, v4, v64
  v_bfi_b32 v65, s32, v4, v65
  global_store_dword v26, v64, s[26:27] sc1
  global_store_dword v26, v65, s[26:27] offset:2048 sc1
  s_mov_b64 exec, -1

  s_waitcnt vmcnt(10)
  s_barrier
  s_add_u32 m0, s56, 32768
  s_add_u32 s42, s41, 0
  buffer_load_dwordx4 v21, s[48:51], s42 offen nt lds
  s_add_u32 m0, s56, 33792
  s_add_u32 s42, s41, 512
  buffer_load_dwordx4 v21, s[48:51], s42 offen nt lds
  s_add_u32 m0, s56, 34816
  s_add_u32 s42, s41, 1024
  buffer_load_dwordx4 v21, s[48:51], s42 offen nt lds
  s_add_u32 m0, s56, 35840
  s_add_u32 s42, s41, 1536
  buffer_load_dwordx4 v21, s[48:51], s42 offen nt lds
  s_add_u32 m0, s56, 36864
  s_add_u32 s42, s41, 2048
  buffer_load_dwordx4 v21, s[48:51], s42 offen nt lds
  s_add_u32 m0, s56, 37888
  s_add_u32 s42, s41, 2560
  buffer_load_dwordx4 v21, s[48:51], s42 offen nt lds
  s_add_u32 m0, s56, 38912
  s_add_u32 s42, s41, 3072
  buffer_load_dwordx4 v21, s[48:51], s42 offen nt lds
  s_add_u32 m0, s56, 39936
  s_add_u32 s42, s41, 3584
  buffer_load_dwordx4 v21, s[48:51], s42 offen nt lds
  v_and_b32 v22, 15, v5
  v_bfe_u32 v23, v5, 1, 3
  v_xor_b32 v23, v23, v13
  v_lshlrev_b32 v23, 4, v23
  v_lshl_add_u32 v22, v22, 7, v23
  v_add_u32 v22, s43, v22
  v_xor_b32 v23, 64, v22
  s_add_u32 s42, s56, 32768

  v_xor_b32 v24, 0, v16
  v_lshl_add_u32 v24, v24, 5, v15
  v_add_u32 v24, s42, v24
  v_xor_b32 v25, 1, v16
  v_lshl_add_u32 v25, v25, 5, v15
  v_add_u32 v25, s42, v25
  v_xor_b32 v26, 2, v16
  v_lshl_add_u32 v26, v26, 5, v15
  v_add_u32 v26, s42, v26
  v_xor_b32 v27, 3, v16
  v_lshl_add_u32 v27, v27, 5, v15
  v_add_u32 v27, s42, v27
  v_and_b32 v28, 1, v5
  v_mul_u32_u24 v28, 576, v28
  v_lshl_add_u32 v28, v13, 4, v28
  v_add_u32 v28, 118784, v28
  s_lshl_b32 s42, s28, 14
  s_lshl_b32 s45, s39, 11
  s_add_u32 s42, s42, s45
  s_lshl_b32 s45, s37, 10
  s_add_u32 s42, s42, s45
  s_lshl_b32 s45, s38, 9
  s_add_u32 s42, s42, s45
  s_add_u32 s42, s42, 4096
  v_lshrrev_b32 v29, 5, v5
  v_and_b32 v30, 31, v5
  v_lshlrev_b32 v31, 12, v29
  v_lshl_add_u32 v31, v30, 4, v31
  v_add_u32 v51, s42, v31
  v_add_u32 v52, 8192, v51
  s_lshl_b32 s42, s28, 7
  s_add_u32 s42, s42, 1024
  v_lshl_add_u32 v50, v30, 2, s42
  s_mul_i32 s42, s37, 576
  s_lshl_b32 s45, s38, 8
  s_add_u32 s42, s42, s45
  s_add_u32 s42, s42, 118784
  v_lshlrev_b32 v30, 3, v30
  v_lshl_add_u32 v30, v29, 2, v30
  v_add_u32 v53, s42, v30
  s_lshl_b32 s42, s28, 1
  s_add_u32 s42, s42, s39
  s_lshl_b32 s42, s42, 4
  s_add_u32 s42, s42, s40
  s_mul_i32 s42, s42, 2176
  s_lshl_b32 s45, s36, 9
  s_add_u32 s42, s42, s45
  s_add_u32 s42, s42, 262144
  v_lshlrev_b32 v54, 3, v5
  v_add_u32 v54, s42, v54
  v_and_b32 v228, 3, v5
  v_lshlrev_b32 v228, 7, v228
  v_add_u32 v228, s42, v228
  v_and_b32 v229, 1, v5
  v_lshlrev_b32 v230, 2, v229
  v_add_u32 v230, 120192, v230
  v_mov_b32 v229, 0xff800000
  s_mov_b64 exec, 3
  ds_write_b32 v230, v229
  s_mov_b64 exec, -1
  v_and_b32 v231, 1, v5
  v_mul_u32_u24 v231, 144, v231
  v_lshl_add_u32 v231, v13, 3, v231
  v_add_u32 v231, 120224, v231
  s_lshl_b32 s45, s36, 5
  v_add_u32 v232, s45, v231
  s_lshl_b32 s42, s28, 1
  s_add_u32 s42, s42, s38
  s_mul_i32 s33, s42, 34816
  s_lshl_b32 s56, s29, 7
  s_add_u32 s33, s33, s56
  s_lshl_b32 s56, s37, 6
  s_add_u32 s33, s33, s56
  s_add_u32 s33, s33, 262144
  v_lshrrev_b32 v6, 2, v5
  v_mul_u32_u24 v7, 2176, v6
  v_and_b32 v62, 3, v5
  v_lshl_add_u32 v7, v62, 4, v7
  v_add_u32 v62, s33, v7
  v_mov_b32 v46, 0x3f803f80
  v_mov_b32 v47, 0x3f803f80
  v_mov_b32 v48, 0x3f803f80
  v_mov_b32 v49, 0x3f803f80
  v_and_b32 v55, 1, v5
  v_cmp_eq_u32 s[58:59], 1, v55

  s_getreg_b32 s34, hwreg(HW_REG_XCC_ID, 0, 4)
  s_lshl_b32 s34, s34, 24
  s_mul_i32 s33, s31, 0x010101
  s_or_b32 s34, s34, s33
  s_mov_b32 s35, 0xffffff
  s_waitcnt vmcnt(8) lgkmcnt(0)
  s_barrier
  ds_read_b128 v[64:67], v22 offset:0
  ds_read_b128 v[68:71], v23 offset:0
  ds_read_b128 v[72:75], v22 offset:8192
  ds_read_b128 v[76:79], v23 offset:8192
  ds_read_b128 v[80:83], v22 offset:16384
  ds_read_b128 v[84:87], v23 offset:16384
  ds_read_b128 v[88:91], v22 offset:24576
  ds_read_b128 v[92:95], v23 offset:24576
  s_cmp_lt_u32 s29, 16
  s_cbranch_scc0 L_q_p
  s_mov_b32 s44, s12
  s_mov_b32 s45, s13
  s_mov_b32 s46, 3670016
  s_mov_b32 s47, 0x20000
  s_mov_b32 s52, s18
  s_mov_b32 s53, s19
  s_mov_b32 s54, 1605632
  s_mov_b32 s55, 0x20000
  s_lshl_b32 s42, s28, 9
  s_lshl_b32 s61, s29, 4
  s_add_u32 s42, s42, s61
  s_lshl_b32 s61, s38, 8
  s_add_u32 s42, s42, s61
  s_lshl_b32 s61, s37, 3
  s_add_u32 s42, s42, s61
  s_mul_i32 s61, s42, 896
  s_lshl_b32 s60, s36, 10
  s_add_u32 s60, s60, 65536
  v_mul_u32_u24 v19, 896, v8
  v_add_u32 v19, v19, v11
  s_lshl_b32 s33, s28, 4
  s_add_u32 s33, s33, s29
  s_min_u32 s42, s33, 111
  s_lshl_b32 s42, s42, 4
  s_lshl_b32 s62, s37, 3
  s_add_u32 s42, s42, s62
  s_mul_i32 s42, s42, 896
  s_lshl_b32 s62, s38, 7
  s_add_u32 s62, s42, s62
  s_cmp_lt_u32 s33, 112
  s_cselect_b32 s33, 0, 0x40000000
  v_add_u32 v20, s33, v19
  s_lshl_b32 s63, s38, 11
  s_lshl_b32 s33, s37, 10
  s_add_u32 s63, s63, s33
  s_add_u32 s63, s63, 94208

  s_waitcnt vmcnt(3)
  global_load_dwordx4 v[32:35], v51, s[26:27] sc1
  global_load_dwordx4 v[36:39], v52, s[26:27] sc1
  global_load_dword v41, v50, s[26:27] sc1
  s_mov_b64 exec, 0xf
  global_load_dword v2, v228, s[26:27] sc1
  s_mov_b64 exec, -1
  s_barrier
  s_add_u32 m0, s60, 0
  s_add_u32 s33, s61, 0
  buffer_load_dwordx4 v19, s[44:47], s33 offen nt lds
  s_add_u32 m0, s60, 4096
  s_add_u32 s33, s61, 128
  buffer_load_dwordx4 v19, s[44:47], s33 offen nt lds
  s_add_u32 m0, s60, 8192
  s_add_u32 s33, s61, 256
  buffer_load_dwordx4 v19, s[44:47], s33 offen nt lds
  s_add_u32 m0, s60, 12288
  s_add_u32 s33, s61, 384
  buffer_load_dwordx4 v19, s[44:47], s33 offen nt lds
  s_add_u32 m0, s60, 16384
  s_add_u32 s33, s61, 512
  buffer_load_dwordx4 v19, s[44:47], s33 offen nt lds
  s_add_u32 m0, s60, 20480
  s_add_u32 s33, s61, 640
  buffer_load_dwordx4 v19, s[44:47], s33 offen nt lds
  s_add_u32 m0, s60, 24576
  s_add_u32 s33, s61, 768
  buffer_load_dwordx4 v19, s[44:47], s33 offen nt lds
  s_add_u32 m0, s63, 0
  s_add_u32 s33, s62, 0
  buffer_load_dwordx4 v20, s[52:55], s33 offen nt lds
  s_add_u32 m0, s63, 4096
  s_add_u32 s33, s62, 256
  buffer_load_dwordx4 v20, s[52:55], s33 offen nt lds
  s_add_u32 m0, s63, 8192
  s_add_u32 s33, s62, 512
  buffer_load_dwordx4 v20, s[52:55], s33 offen nt lds
  s_cmp_lg_u32 s38, 0
  s_cbranch_scc1 L_w2_donea
  s_add_u32 m0, s63, 12288
  s_add_u32 s33, s62, 768
  buffer_load_dwordx4 v20, s[52:55], s33 offen nt lds
L_w2_donea:
  s_mov_b32 s33, 0
  s_cmp_lg_u32 s38, 0
  s_cbranch_scc1 L_qw10
  s_waitcnt vmcnt(12)
  s_branch L_qchk
L_qw10:
  s_waitcnt vmcnt(11)
  s_branch L_qchk
L_q_p:
  s_mov_b32 s33, 0
  s_waitcnt vmcnt(3)

  global_load_dwordx4 v[32:35], v51, s[26:27] sc1
  global_load_dwordx4 v[36:39], v52, s[26:27] sc1
  global_load_dword v41, v50, s[26:27] sc1
  s_mov_b64 exec, 0xf
  global_load_dword v2, v228, s[26:27] sc1
  s_mov_b64 exec, -1
  s_waitcnt vmcnt(1)
  s_branch L_qchk
L_qpoll:
  global_load_dwordx4 v[32:35], v51, s[26:27] sc1
  global_load_dwordx4 v[36:39], v52, s[26:27] sc1
  global_load_dword v41, v50, s[26:27] sc1
  s_waitcnt vmcnt(0)
L_qchk:
  v_xor_b32 v32, s31, v32
  v_xor_b32 v33, s31, v33
  v_xor_b32 v34, s31, v34
  v_xor_b32 v35, s31, v35
  v_xor_b32 v36, s31, v36
  v_xor_b32 v37, s31, v37
  v_xor_b32 v38, s31, v38
  v_xor_b32 v39, s31, v39
  v_or3_b32 v40, v32, v33, v34
  v_or3_b32 v40, v40, v35, v36
  v_or3_b32 v40, v40, v37, v38
  v_or_b32 v40, v40, v39
  v_xor_b32 v41, s34, v41
  v_and_b32 v40, 0xff, v40
  v_and_or_b32 v40, v41, s35, v40
  v_cmp_ne_u32 vcc, 0, v40
  s_add_u32 s33, s33, 1
  s_cmp_gt_u32 s33, 400000
  s_cbranch_scc1 L_qok
  s_cbranch_vccnz L_qpoll
L_qok:
  v_add_f32 v32, v32, v36
  v_add_f32 v33, v33, v37
  v_add_f32 v34, v34, v38
  v_add_f32 v35, v35, v39
  v_cmp_ne_u32 vcc, 0, v41
  s_nop 0
  v_permlane32_swap_b32 v32, v34
  v_permlane32_swap_b32 v33, v35
  v_add_f32 v32, v32, v34
  v_add_f32 v33, v33, v35
  v_cvt_pk_bf16_f32 v32, v32, v33
  ds_write_b32 v53, v32
  s_cmp_eq_u64 vcc, 0
  s_cselect_b32 s35, 1, 0
  s_waitcnt lgkmcnt(0)
  s_barrier

  ds_read_b128 v[128:131], v28 offset:0
  ds_read_b128 v[132:135], v28 offset:64
  ds_read_b128 v[136:139], v28 offset:128
  ds_read_b128 v[140:143], v28 offset:192
  ds_read_b128 v[144:147], v28 offset:256
  ds_read_b128 v[148:151], v28 offset:320
  ds_read_b128 v[152:155], v28 offset:384
  ds_read_b128 v[156:159], v28 offset:448
  s_mov_b32 s42, 0x3db8aa3b
  s_waitcnt lgkmcnt(7)
  v_mfma_f32_16x16x32_bf16 v[32:35], v[64:67], v[128:131], 0
  ds_read_b64_tr_b16 v[160:161], v24 offset:0
  s_waitcnt lgkmcnt(7)
  v_mfma_f32_16x16x32_bf16 v[32:35], v[68:71], v[132:135], v[32:35]
  ds_read_b64_tr_b16 v[162:163], v24 offset:2048
  s_waitcnt lgkmcnt(7)
  v_mfma_f32_16x16x32_bf16 v[32:35], v[72:75], v[136:139], v[32:35]
  ds_read_b64_tr_b16 v[164:165], v25 offset:0
  s_waitcnt lgkmcnt(7)
  v_mfma_f32_16x16x32_bf16 v[32:35], v[76:79], v[140:143], v[32:35]
  ds_read_b64_tr_b16 v[166:167], v25 offset:2048
  s_waitcnt lgkmcnt(7)
  v_mfma_f32_16x16x32_bf16 v[32:35], v[80:83], v[144:147], v[32:35]
  ds_read_b64_tr_b16 v[168:169], v26 offset:0
  s_waitcnt lgkmcnt(7)
  v_mfma_f32_16x16x32_bf16 v[32:35], v[84:87], v[148:151], v[32:35]
  ds_read_b64_tr_b16 v[170:171], v26 offset:2048
  s_waitcnt lgkmcnt(7)
  v_mfma_f32_16x16x32_bf16 v[32:35], v[88:91], v[152:155], v[32:35]
  ds_read_b64_tr_b16 v[172:173], v27 offset:0
  s_waitcnt lgkmcnt(7)
  v_mfma_f32_16x16x32_bf16 v[32:35], v[92:95], v[156:159], v[32:35]
  ds_read_b64_tr_b16 v[174:175], v27 offset:2048
  s_mov_b32 s56, 0x00030003
  s_mov_b32 s57, 0x00030003
  s_nop 4
  v_max3_f32 v44, v32, v33, v34
  v_max_f32 v44, v44, v35
  s_mov_b64 exec, s[56:57]
  ds_max_f32 v230, v44
  s_mov_b64 exec, -1
  s_waitcnt lgkmcnt(0)
  s_barrier
  ds_read_b32 v44, v230

  ds_read_b64_tr_b16 v[176:177], v24 offset:4096
  ds_read_b64_tr_b16 v[178:179], v24 offset:6144
  ds_read_b64_tr_b16 v[180:181], v25 offset:4096
  ds_read_b64_tr_b16 v[182:183], v25 offset:6144
  ds_read_b64_tr_b16 v[184:185], v26 offset:4096
  ds_read_b64_tr_b16 v[186:187], v26 offset:6144
  ds_read_b64_tr_b16 v[188:189], v27 offset:4096
  ds_read_b64_tr_b16 v[190:191], v27 offset:6144
  s_waitcnt lgkmcnt(8)
  v_mul_f32 v44, s42, v44

  v_fma_f32 v32, v32, s42, -v44
  v_fma_f32 v33, v33, s42, -v44
  v_fma_f32 v34, v34, s42, -v44
  v_fma_f32 v35, v35, s42, -v44
  v_exp_f32 v32, v32
  v_exp_f32 v33, v33
  v_exp_f32 v34, v34
  v_exp_f32 v35, v35
  s_nop 0
  v_cvt_pk_bf16_f32 v40, v32, v33
  v_cvt_pk_bf16_f32 v41, v34, v35
  s_mov_b64 exec, s[56:57]
  ds_write_b64 v232, v[40:41]
  s_mov_b64 exec, -1
  s_waitcnt lgkmcnt(0)
  s_barrier
  ds_read2_b64 v[32:35], v231 offset0:0 offset1:4
  ds_read2_b64 v[36:39], v231 offset0:8 offset1:12
  s_waitcnt lgkmcnt(1)
  v_mfma_f32_16x16x32_bf16 v[224:227], v[32:35], v[46:49], 0

  v_mfma_f32_16x16x32_bf16 v[192:195], v[32:35], v[160:163], 0
  v_mfma_f32_16x16x32_bf16 v[196:199], v[32:35], v[164:167], 0
  v_mfma_f32_16x16x32_bf16 v[200:203], v[32:35], v[168:171], 0
  v_mfma_f32_16x16x32_bf16 v[204:207], v[32:35], v[172:175], 0
  s_waitcnt lgkmcnt(0)
  v_mfma_f32_16x16x32_bf16 v[224:227], v[36:39], v[46:49], v[224:227]
  v_mfma_f32_16x16x32_bf16 v[192:195], v[36:39], v[176:179], v[192:195]
  v_mfma_f32_16x16x32_bf16 v[196:199], v[36:39], v[180:183], v[196:199]
  v_mfma_f32_16x16x32_bf16 v[200:203], v[36:39], v[184:187], v[200:203]
  v_mfma_f32_16x16x32_bf16 v[204:207], v[36:39], v[188:191], v[204:207]
  s_cmp_eq_u32 s35, 1
  s_nop 2
  v_cndmask_b32 v45, v224, v225, s[58:59]
  v_rcp_f32 v56, v224
  v_rcp_f32 v57, v225
  v_log_f32 v45, v45
  s_nop 0
  v_add_f32 v45, v45, v44

  v_bfi_b32 v59, s32, v4, v45
  v_mul_f32_dpp v32, v192, v56 quad_perm:[0,1,2,3] row_mask:0x1 bank_mask:0xf
  v_mul_f32_dpp v32, v196, v56 quad_perm:[0,1,2,3] row_mask:0x2 bank_mask:0xf
  v_mul_f32_dpp v32, v200, v56 quad_perm:[0,1,2,3] row_mask:0x4 bank_mask:0xf
  v_mul_f32_dpp v32, v204, v56 quad_perm:[0,1,2,3] row_mask:0x8 bank_mask:0xf
  v_mul_f32_dpp v33, v193, v57 quad_perm:[0,1,2,3] row_mask:0x1 bank_mask:0xf
  v_mul_f32_dpp v33, v197, v57 quad_perm:[0,1,2,3] row_mask:0x2 bank_mask:0xf
  v_mul_f32_dpp v33, v201, v57 quad_perm:[0,1,2,3] row_mask:0x4 bank_mask:0xf
  v_mul_f32_dpp v33, v205, v57 quad_perm:[0,1,2,3] row_mask:0x8 bank_mask:0xf
  v_cvt_pk_bf16_f32 v58, v32, v33
  s_cbranch_scc1 L_pub_local
  global_store_dwordx2 v54, v[58:59], s[26:27] sc1
  s_branch L_pub_done
L_pub_local:
  global_store_dwordx2 v54, v[58:59], s[26:27]
L_pub_done:

  s_cmp_lt_u32 s29, 16
  s_cbranch_scc1 L_wstage
  s_barrier
  s_endpgm
L_wstage:
  v_xor_b32 v24, s36, v16
  v_lshl_add_u32 v24, v24, 5, v15
  v_add_u32 v25, 94208, v24
  v_add_u32 v24, 65536, v24
  v_and_b32 v26, 1, v5
  v_lshlrev_b32 v27, 5, v26
  v_lshl_add_u32 v27, v13, 3, v27
  v_add_u32 v27, 120064, v27
  v_lshlrev_b32 v28, 6, v26
  v_lshl_add_u32 v28, v13, 3, v28
  v_add_u32 v28, 119936, v28
  v_and_b32 v54, 3, v5
  v_lshlrev_b32 v54, 2, v54
  v_and_b32 v55, 1, v13
  v_lshl_add_u32 v54, v55, 5, v54
  v_lshrrev_b32 v55, 1, v13
  v_lshl_add_u32 v54, v55, 1, v54
  s_lshl_b32 s42, s38, 6
  s_lshl_b32 s45, s37, 4
  s_add_u32 s42, s42, s45
  s_add_u32 s42, s42, 119936
  v_add_u32 v54, s42, v54
  s_lshl_b32 s42, s28, 4
  s_add_u32 s42, s42, s29
  s_mul_i32 s42, s42, 7296
  s_lshl_b32 s45, s36, 8
  s_add_u32 s42, s42, s45
  s_add_u32 s42, s42, 1572864
  v_lshlrev_b32 v55, 3, v5
  v_add_u32 v55, s42, v55
  v_and_b32 v56, 7, v5
  v_lshlrev_b32 v56, 3, v56
  v_bfe_u32 v57, v5, 3, 1
  v_lshl_add_u32 v56, v57, 7, v56
  v_lshl_add_u32 v56, v13, 10, v56
  v_add_u32 v56, s42, v56
  v_add_u32 v57, 4096, v56
  s_lshl_b32 s42, s38, 2
  s_add_u32 s42, s42, 120128
  v_mov_b32 v29, s42
  ds_read_b32 v50, v29
  s_mov_b32 s56, 0xf000f000
  s_mov_b32 s57, 0xf000f000
  s_mov_b32 s33, 0
  s_waitcnt vmcnt(0) lgkmcnt(0)

  s_barrier
  global_load_dwordx4 v[32:35], v62, s[26:27] sc1
  ds_read_b64 v[106:107], v27
  ds_read_b64_tr_b16 v[92:93], v25 offset:0
  ds_read_b64_tr_b16 v[94:95], v25 offset:2048
  ds_read_b64_tr_b16 v[96:97], v25 offset:4096
  ds_read_b64_tr_b16 v[98:99], v25 offset:6144
  ds_read_b64_tr_b16 v[100:101], v25 offset:8192
  ds_read_b64_tr_b16 v[102:103], v25 offset:10240
  ds_read_b64_tr_b16 v[104:105], v25 offset:12288
  s_waitcnt lgkmcnt(0)
  v_mfma_f32_16x16x16_bf16 v[110:113], v[106:107], v[92:93], 0
  v_mfma_f32_16x16x16_bf16 v[114:117], v[106:107], v[94:95], 0
  v_mfma_f32_16x16x16_bf16 v[118:121], v[106:107], v[96:97], 0
  v_mfma_f32_16x16x16_bf16 v[122:125], v[106:107], v[98:99], 0
  v_mfma_f32_16x16x16_bf16 v[126:129], v[106:107], v[100:101], 0
  v_mfma_f32_16x16x16_bf16 v[130:133], v[106:107], v[102:103], 0
  v_mfma_f32_16x16x16_bf16 v[134:137], v[106:107], v[104:105], 0
  s_waitcnt vmcnt(0)
  s_branch L_ochk
L_opoll:
  global_load_dwordx4 v[32:35], v62, s[26:27] sc1
  s_waitcnt vmcnt(0)
L_ochk:

  v_xor_b32 v33, s31, v33
  v_xor_b32 v35, s31, v35
  v_or_b32 v48, v33, v35
  v_and_b32 v48, 0xff, v48
  v_cmp_ne_u32 vcc, 0, v48
  s_add_u32 s33, s33, 1
  s_cmp_gt_u32 s33, 400000
  s_cbranch_scc1 L_ook
  s_cbranch_vccnz L_opoll
L_ook:
  v_mov_b32 v52, v33
  v_mov_b32 v53, v35
  v_lshlrev_b32 v40, 16, v32
  v_and_b32 v41, 0xffff0000, v32
  v_permlane16_swap_b32 v52, v53
  v_lshlrev_b32 v42, 16, v34
  v_and_b32 v43, 0xffff0000, v34
  v_max_f32 v52, v52, v53
  v_mov_b32 v53, v52
  ds_read_b64_tr_b16 v[64:65], v24 offset:0
  ds_read_b64_tr_b16 v[66:67], v24 offset:2048
  v_permlane32_swap_b32 v52, v53
  v_max_f32 v52, v52, v53
  ds_read_b64_tr_b16 v[68:69], v24 offset:4096
  ds_read_b64_tr_b16 v[70:71], v24 offset:6144
  v_max_f32_dpp v52, v52, v52 row_shr:4 row_mask:0xf bank_mask:0xf
  ds_read_b64_tr_b16 v[72:73], v24 offset:8192
  ds_read_b64_tr_b16 v[74:75], v24 offset:10240
  v_max_f32_dpp v52, v52, v52 row_shr:8 row_mask:0xf bank_mask:0xf
  ds_read_b64_tr_b16 v[76:77], v24 offset:12288
  v_readlane_b32 s42, v52, 15
  v_readlane_b32 s45, v52, 31
  ds_read_b64_tr_b16 v[78:79], v24 offset:14336
  ds_read_b64_tr_b16 v[80:81], v24 offset:16384
  v_subrev_f32 v33, s42, v33
  v_subrev_f32 v35, s45, v35
  v_exp_f32 v52, v33
  v_exp_f32 v53, v35
  ds_read_b64_tr_b16 v[82:83], v24 offset:18432
  v_mul_f32 v40, v40, v52
  v_mul_f32 v41, v41, v53
  v_mul_f32 v42, v42, v52
  v_mul_f32 v43, v43, v53
  ds_read_b64_tr_b16 v[84:85], v24 offset:20480
  v_permlane16_swap_b32 v40, v41
  v_permlane16_swap_b32 v42, v43
  v_permlane16_swap_b32 v52, v53
  v_add_f32 v40, v40, v41
  v_add_f32 v42, v42, v43
  v_add_f32 v52, v52, v53
  v_mov_b32 v53, v52
  ds_read_b64_tr_b16 v[86:87], v24 offset:22528
  ds_read_b64_tr_b16 v[88:89], v24 offset:24576
  v_permlane32_swap_b32 v40, v42
  v_permlane32_swap_b32 v52, v53
  v_add_f32 v40, v40, v42
  v_add_f32 v52, v52, v53
  ds_read_b64_tr_b16 v[90:91], v24 offset:26624
  v_add_f32_dpp v40, v40, v40 row_shr:4 row_mask:0xf bank_mask:0xf
  v_add_f32_dpp v52, v52, v52 row_shr:4 row_mask:0xf bank_mask:0xf
  s_nop 0
  v_add_f32_dpp v40, v40, v40 row_shr:8 row_mask:0xf bank_mask:0xf
  v_add_f32_dpp v52, v52, v52 row_shr:8 row_mask:0xf bank_mask:0xf
  v_mul_f32 v40, v40, v50
  v_rcp_f32 v52, v52
  s_mov_b64 exec, s[56:57]
  v_mul_f32 v40, v40, v52
  v_cvt_pk_bf16_f32 v40, v40, v40
  ds_write_b16 v54, v40
  s_mov_b64 exec, -1
  s_waitcnt lgkmcnt(0)
  s_barrier

  ds_read2_b64 v[40:43], v28 offset0:0 offset1:4
  s_waitcnt lgkmcnt(0)

  v_mfma_f32_16x16x32_bf16 v[110:113], v[40:43], v[64:67], v[110:113]
  v_mfma_f32_16x16x32_bf16 v[114:117], v[40:43], v[68:71], v[114:117]
  v_mfma_f32_16x16x32_bf16 v[118:121], v[40:43], v[72:75], v[118:121]
  v_mfma_f32_16x16x32_bf16 v[122:125], v[40:43], v[76:79], v[122:125]
  v_mfma_f32_16x16x32_bf16 v[126:129], v[40:43], v[80:83], v[126:129]
  v_mfma_f32_16x16x32_bf16 v[130:133], v[40:43], v[84:87], v[130:133]
  v_mfma_f32_16x16x32_bf16 v[134:137], v[40:43], v[88:91], v[134:137]
  s_mov_b32 s56, -1
  s_mov_b32 s57, 0xffff
  s_nop 0
  v_mov_b32_dpp v110, v114 quad_perm:[0,1,2,3] row_mask:0x2 bank_mask:0xf
  v_mov_b32_dpp v111, v115 quad_perm:[0,1,2,3] row_mask:0x2 bank_mask:0xf
  v_mov_b32_dpp v110, v118 quad_perm:[0,1,2,3] row_mask:0x4 bank_mask:0xf
  v_mov_b32_dpp v111, v119 quad_perm:[0,1,2,3] row_mask:0x4 bank_mask:0xf
  v_mov_b32_dpp v110, v122 quad_perm:[0,1,2,3] row_mask:0x8 bank_mask:0xf
  v_mov_b32_dpp v111, v123 quad_perm:[0,1,2,3] row_mask:0x8 bank_mask:0xf
  v_bfi_b32 v110, s32, v4, v110
  global_store_dwordx2 v56, v[110:111], s[26:27] sc1
  v_mov_b32_dpp v126, v130 quad_perm:[0,1,2,3] row_mask:0x2 bank_mask:0xf
  v_mov_b32_dpp v127, v131 quad_perm:[0,1,2,3] row_mask:0x2 bank_mask:0xf
  v_mov_b32_dpp v126, v134 quad_perm:[0,1,2,3] row_mask:0x4 bank_mask:0xf
  v_mov_b32_dpp v127, v135 quad_perm:[0,1,2,3] row_mask:0x4 bank_mask:0xf
  v_bfi_b32 v126, s32, v4, v126
  s_mov_b64 exec, s[56:57]
  global_store_dwordx2 v57, v[126:127], s[26:27] sc1
  s_mov_b64 exec, -1
  s_endpgm
L_aux0:
  s_lshr_b32 s29, s2, 3
  s_mov_b32 s32, 0xff
  v_lshrrev_b32 v13, 4, v5
  v_lshlrev_b32 v18, 4, v5
  v_add_u32 v21, 1024, v18
  s_waitcnt lgkmcnt(0)
  s_load_dword s31, s[26:27], 0

  s_mov_b32 s52, s4
  s_mov_b32 s53, s5
  s_mov_b32 s54, 1792
  s_mov_b32 s55, 0x20000
  s_mov_b32 m0, 116736
  s_cmp_ge_u32 s29, 16
  buffer_load_dwordx4 v18, s[52:55], 0 offen lds
  s_mov_b32 m0, 117760
  s_nop 0
  buffer_load_dwordx4 v21, s[52:55], 0 offen lds
  s_cbranch_scc1 L_aux
  s_mov_b32 s56, -1
  s_mov_b32 s57, 0x00ffffff
  s_mov_b64 exec, s[56:57]
  global_load_dwordx4 v[70:73], v18, s[4:5]
  global_load_dwordx4 v[74:77], v18, s[4:5] offset:896
  global_load_dwordx4 v[78:81], v18, s[20:21]
  s_mov_b64 exec, -1

L_aux:
  v_bfe_u32 v14, v5, 2, 2
  v_lshl_add_u32 v15, v13, 2, v14
  v_bfe_u32 v16, v15, 1, 2
  v_and_b32 v17, 3, v5
  v_lshlrev_b32 v15, 7, v15
  v_lshl_add_u32 v15, v17, 3, v15
  v_xor_b32 v24, 0, v16
  v_lshl_add_u32 v24, v24, 5, v15
  v_add_u32 v24, 108544, v24
  v_xor_b32 v25, 1, v16
  v_lshl_add_u32 v25, v25, 5, v15
  v_add_u32 v25, 108544, v25
  v_xor_b32 v26, 2, v16
  v_lshl_add_u32 v26, v26, 5, v15
  v_add_u32 v26, 108544, v26
  v_xor_b32 v27, 3, v16
  v_lshl_add_u32 v27, v27, 5, v15
  v_add_u32 v27, 108544, v27
  s_lshl_b32 s39, s28, 4
  s_add_u32 s39, s39, s29
  s_sub_u32 s39, s39, 16
  s_lshl_b32 s33, s29, 3
  s_add_u32 s33, s33, s28
  s_add_u32 s33, s33, 128
  s_cmp_lt_u32 s29, 16
  s_cselect_b32 s39, s33, s39
  s_mul_i32 s40, s39, 9363
  s_lshr_b32 s40, s40, 16
  s_mul_i32 s41, s40, 7
  s_sub_u32 s41, s39, s41
  v_and_b32 v28, 1, v5
  v_mul_u32_u24 v28, 896, v28
  v_lshl_add_u32 v28, v13, 3, v28
  s_lshl_b32 s42, s41, 7
  s_add_u32 s42, s42, 116736
  v_add_u32 v28, s42, v28
  s_mul_i32 s42, s41, 14336
  s_lshl_b32 s43, s40, 8
  s_add_u32 s42, s42, s43
  s_add_u32 s42, s42, 135168
  v_lshlrev_b32 v31, 2, v5
  v_add_u32 v31, s42, v31
  v_add_u32 v30, 7168, v31
  s_waitcnt lgkmcnt(0)

  s_and_b32 s31, s31, 0xff
  s_mul_i32 s31, s31, 5
  s_add_u32 s31, s31, 59
  s_and_b32 s31, s31, 0xff
  v_mov_b32 v4, s31
  s_getreg_b32 s34, hwreg(HW_REG_XCC_ID, 0, 4)
  s_lshl_b32 s34, s34, 24
  s_mul_i32 s33, s31, 0x010101
  s_or_b32 s34, s34, s33
  s_lshl_b32 s42, s28, 7
  s_lshl_b32 s43, s29, 2
  s_add_u32 s42, s42, s43
  s_add_u32 s42, s42, 1024
  v_mov_b32 v6, s42
  v_mov_b32 v7, s34
  s_waitcnt vmcnt(0)
  s_mov_b64 exec, 1
  global_store_dword v6, v7, s[26:27] sc1
  s_mov_b64 exec, -1
  s_barrier
  s_barrier

  s_cmp_ge_u32 s39, 196
  s_cbranch_scc1 L_nohpub
  ds_read2_b64 v[48:51], v28 offset0:0 offset1:4
  ds_read_b64_tr_b16 v[96:97], v24 offset:0
  ds_read_b64_tr_b16 v[98:99], v24 offset:2048
  ds_read_b64_tr_b16 v[100:101], v25 offset:0
  ds_read_b64_tr_b16 v[102:103], v25 offset:2048
  ds_read_b64_tr_b16 v[104:105], v26 offset:0
  ds_read_b64_tr_b16 v[106:107], v26 offset:2048
  ds_read_b64_tr_b16 v[108:109], v27 offset:0
  ds_read_b64_tr_b16 v[110:111], v27 offset:2048
  ds_read2_b64 v[52:55], v28 offset0:8 offset1:12
  ds_read_b64_tr_b16 v[112:113], v24 offset:4096
  ds_read_b64_tr_b16 v[114:115], v24 offset:6144
  ds_read_b64_tr_b16 v[116:117], v25 offset:4096
  ds_read_b64_tr_b16 v[118:119], v25 offset:6144
  ds_read_b64_tr_b16 v[120:121], v26 offset:4096
  ds_read_b64_tr_b16 v[122:123], v26 offset:6144
  ds_read_b64_tr_b16 v[124:125], v27 offset:4096
  ds_read_b64_tr_b16 v[126:127], v27 offset:6144
  s_waitcnt lgkmcnt(9)
  v_mfma_f32_16x16x32_bf16 v[32:35], v[48:51], v[96:99], 0
  v_mfma_f32_16x16x32_bf16 v[36:39], v[48:51], v[100:103], 0
  v_mfma_f32_16x16x32_bf16 v[40:43], v[48:51], v[104:107], 0
  v_mfma_f32_16x16x32_bf16 v[44:47], v[48:51], v[108:111], 0
  s_waitcnt lgkmcnt(0)
  v_mfma_f32_16x16x32_bf16 v[32:35], v[52:55], v[112:115], v[32:35]
  v_mfma_f32_16x16x32_bf16 v[36:39], v[52:55], v[116:119], v[36:39]
  v_mfma_f32_16x16x32_bf16 v[40:43], v[52:55], v[120:123], v[40:43]
  v_mfma_f32_16x16x32_bf16 v[44:47], v[52:55], v[124:127], v[44:47]
  s_nop 7
  v_permlane16_swap_b32 v32, v36
  v_permlane16_swap_b32 v40, v44
  v_permlane16_swap_b32 v33, v37
  v_permlane16_swap_b32 v41, v45
  s_nop 1
  v_permlane32_swap_b32 v32, v40
  v_permlane32_swap_b32 v33, v41
  s_nop 1
  v_bfi_b32 v32, s32, v4, v32
  v_bfi_b32 v33, s32, v4, v33
  global_store_dword v31, v32, s[26:27] sc1
  global_store_dword v30, v33, s[26:27] sc1
L_nohpub:
  s_cmp_ge_u32 s29, 16
  s_cbranch_scc1 L_aux_a
  v_mov_b32 v44, 0
  v_mov_b32 v45, 0
  v_lshlrev_b32 v46, 16, v78
  v_and_b32 v47, 0xffff0000, v78
  v_lshlrev_b32 v48, 16, v70
  v_and_b32 v49, 0xffff0000, v70
  v_mul_f32 v48, v48, v46
  v_mul_f32 v49, v49, v47
  v_cvt_pk_bf16_f32 v48, v48, v49
  v_lshlrev_b32 v49, 16, v48
  v_and_b32 v48, 0xffff0000, v48
  v_add_f32 v44, v44, v49
  v_add_f32 v44, v44, v48
  v_lshlrev_b32 v48, 16, v74
  v_and_b32 v49, 0xffff0000, v74
  v_mul_f32 v48, v48, v46
  v_mul_f32 v49, v49, v47
  v_cvt_pk_bf16_f32 v48, v48, v49
  v_lshlrev_b32 v49, 16, v48
  v_and_b32 v48, 0xffff0000, v48
  v_add_f32 v45, v45, v49
  v_add_f32 v45, v45, v48
  v_lshlrev_b32 v46, 16, v79
  v_and_b32 v47, 0xffff0000, v79
  v_lshlrev_b32 v48, 16, v71
  v_and_b32 v49, 0xffff0000, v71
  v_mul_f32 v48, v48, v46
  v_mul_f32 v49, v49, v47
  v_cvt_pk_bf16_f32 v48, v48, v49
  v_lshlrev_b32 v49, 16, v48
  v_and_b32 v48, 0xffff0000, v48
  v_add_f32 v44, v44, v49
  v_add_f32 v44, v44, v48
  v_lshlrev_b32 v48, 16, v75
  v_and_b32 v49, 0xffff0000, v75
  v_mul_f32 v48, v48, v46
  v_mul_f32 v49, v49, v47
  v_cvt_pk_bf16_f32 v48, v48, v49
  v_lshlrev_b32 v49, 16, v48
  v_and_b32 v48, 0xffff0000, v48
  v_add_f32 v45, v45, v49
  v_add_f32 v45, v45, v48
  v_lshlrev_b32 v46, 16, v80
  v_and_b32 v47, 0xffff0000, v80
  v_lshlrev_b32 v48, 16, v72
  v_and_b32 v49, 0xffff0000, v72
  v_mul_f32 v48, v48, v46
  v_mul_f32 v49, v49, v47
  v_cvt_pk_bf16_f32 v48, v48, v49
  v_lshlrev_b32 v49, 16, v48
  v_and_b32 v48, 0xffff0000, v48
  v_add_f32 v44, v44, v49
  v_add_f32 v44, v44, v48
  v_lshlrev_b32 v48, 16, v76
  v_and_b32 v49, 0xffff0000, v76
  v_mul_f32 v48, v48, v46
  v_mul_f32 v49, v49, v47
  v_cvt_pk_bf16_f32 v48, v48, v49
  v_lshlrev_b32 v49, 16, v48
  v_and_b32 v48, 0xffff0000, v48
  v_add_f32 v45, v45, v49
  v_add_f32 v45, v45, v48
  v_lshlrev_b32 v46, 16, v81
  v_and_b32 v47, 0xffff0000, v81
  v_lshlrev_b32 v48, 16, v73
  v_and_b32 v49, 0xffff0000, v73
  v_mul_f32 v48, v48, v46
  v_mul_f32 v49, v49, v47
  v_cvt_pk_bf16_f32 v48, v48, v49
  v_lshlrev_b32 v49, 16, v48
  v_and_b32 v48, 0xffff0000, v48
  v_add_f32 v44, v44, v49
  v_add_f32 v44, v44, v48
  v_lshlrev_b32 v48, 16, v77
  v_and_b32 v49, 0xffff0000, v77
  v_mul_f32 v48, v48, v46
  v_mul_f32 v49, v49, v47
  v_cvt_pk_bf16_f32 v48, v48, v49
  v_lshlrev_b32 v49, 16, v48
  v_and_b32 v48, 0xffff0000, v48
  v_add_f32 v45, v45, v49
  v_add_f32 v45, v45, v48
  v_cmp_gt_u32 vcc, 56, v5
  s_nop 1
  v_cndmask_b32 v44, 0, v44, vcc
  v_cndmask_b32 v45, 0, v45, vcc
  s_nop 1

  v_add_f32_dpp v44, v44, v44 row_shr:1 row_mask:0xf bank_mask:0xf
  v_add_f32_dpp v45, v45, v45 row_shr:1 row_mask:0xf bank_mask:0xf
  s_nop 0
  v_add_f32_dpp v44, v44, v44 row_shr:2 row_mask:0xf bank_mask:0xf
  v_add_f32_dpp v45, v45, v45 row_shr:2 row_mask:0xf bank_mask:0xf
  s_nop 0
  v_add_f32_dpp v44, v44, v44 row_shr:4 row_mask:0xf bank_mask:0xf
  v_add_f32_dpp v45, v45, v45 row_shr:4 row_mask:0xf bank_mask:0xf
  s_nop 0
  v_add_f32_dpp v44, v44, v44 row_shr:8 row_mask:0xf bank_mask:0xf
  v_add_f32_dpp v45, v45, v45 row_shr:8 row_mask:0xf bank_mask:0xf
  s_nop 0
  v_add_f32_dpp v44, v44, v44 row_bcast:15 row_mask:0xa bank_mask:0xf
  v_add_f32_dpp v45, v45, v45 row_bcast:15 row_mask:0xa bank_mask:0xf
  s_nop 0
  v_add_f32_dpp v44, v44, v44 row_bcast:31 row_mask:0xc bank_mask:0xf
  v_add_f32_dpp v45, v45, v45 row_bcast:31 row_mask:0xc bank_mask:0xf
  s_nop 0
  v_readlane_b32 s42, v44, 63
  v_readlane_b32 s43, v45, 63
  s_nop 1
  v_and_b32 v46, 1, v5
  v_cmp_eq_u32 vcc, 0, v46
  v_mov_b32 v47, s43
  v_mov_b32 v48, s42
  v_cndmask_b32 v47, v47, v48, vcc
  v_mul_f32 v47, 0xbfb8aa3b, v47
  v_exp_f32 v47, v47
  s_nop 0
  v_add_f32 v47, 1.0, v47
  v_rcp_f32 v47, v47
  s_nop 0
  v_sub_f32 v82, 1.0, v47
  v_lshlrev_b32 v46, 2, v46
  v_add_u32 v46, 120128, v46
  s_mov_b64 exec, 3
  ds_write_b32 v46, v47
  s_mov_b64 exec, -1
  s_waitcnt lgkmcnt(0)

L_aux_a:
  s_barrier
  s_cmp_lt_u32 s29, 16
  s_cbranch_scc1 L_aux_w
  s_cmp_lt_u32 s29, 23
  s_cbranch_scc1 L_final
  s_endpgm
L_final:
  s_sub_u32 s36, s29, 16
  s_lshl_b32 s37, s36, 3
  s_add_u32 s37, s37, s28
  v_lshrrev_b32 v29, 2, v5
  v_mul_u32_u24 v30, 7296, v29
  v_and_b32 v31, 3, v5
  v_lshl_add_u32 v30, v31, 4, v30
  s_lshl_b32 s42, s37, 7
  s_add_u32 s42, s42, 1572864
  v_add_u32 v30, s42, v30

  v_add_u32 v16, 0, v30
  v_add_u32 v17, 116736, v30
  v_add_u32 v18, 233472, v30
  v_add_u32 v19, 350208, v30
  v_add_u32 v20, 466944, v30
  v_add_u32 v21, 583680, v30
  v_add_u32 v22, 700416, v30
  v_add_u32 v23, 817152, v30
  v_and_b32 v28, 1, v13
  v_mul_u32_u24 v28, 896, v28
  v_lshl_add_u32 v28, v31, 2, v28
  v_lshrrev_b32 v29, 1, v13
  v_lshl_add_u32 v28, v29, 1, v28
  s_lshl_b32 s42, s37, 4
  v_add_u32 v28, s42, v28
  s_mov_b32 s56, 0xf000f000
  s_mov_b32 s57, 0xf000f000
  v_mov_b32 v29, 0
  s_barrier
  s_barrier
  s_barrier
  s_barrier
  s_mov_b32 s33, 0

  s_mul_i32 s42, s28, 69632
  s_add_u32 s42, s42, 262144
  v_and_b32 v24, 31, v5
  v_mul_u32_u24 v24, 2176, v24
  v_add_u32 v24, s42, v24
L_fgate:
  global_load_dwordx4 v[32:35], v24, s[26:27] sc1
  s_waitcnt vmcnt(0)

  v_xor_b32 v33, s31, v33
  v_xor_b32 v35, s31, v35
  v_or_b32 v14, v33, v35
  v_and_b32 v14, 0xff, v14
  v_cmp_ne_u32 vcc, 0, v14
  s_add_u32 s33, s33, 1
  s_cmp_gt_u32 s33, 400000
  s_cbranch_scc1 L_fgate_ok
  s_cbranch_vccnz L_fgate
L_fgate_ok:
  global_load_dwordx4 v[32:35], v16, s[26:27] sc1
  global_load_dwordx4 v[36:39], v17, s[26:27] sc1
  global_load_dwordx4 v[40:43], v18, s[26:27] sc1
  global_load_dwordx4 v[44:47], v19, s[26:27] sc1
  global_load_dwordx4 v[48:51], v20, s[26:27] sc1
  global_load_dwordx4 v[52:55], v21, s[26:27] sc1
  global_load_dwordx4 v[56:59], v22, s[26:27] sc1
  global_load_dwordx4 v[60:63], v23, s[26:27] sc1
L_fpoll:
  s_waitcnt vmcnt(0)
  v_xor_b32 v32, s31, v32
  v_xor_b32 v34, s31, v34
  v_xor_b32 v36, s31, v36
  v_xor_b32 v38, s31, v38
  v_xor_b32 v40, s31, v40
  v_xor_b32 v42, s31, v42
  v_xor_b32 v44, s31, v44
  v_xor_b32 v46, s31, v46
  v_xor_b32 v48, s31, v48
  v_xor_b32 v50, s31, v50
  v_xor_b32 v52, s31, v52
  v_xor_b32 v54, s31, v54
  v_xor_b32 v56, s31, v56
  v_xor_b32 v58, s31, v58
  v_xor_b32 v60, s31, v60
  v_xor_b32 v62, s31, v62
  v_or3_b32 v14, v32, v34, v36
  v_or3_b32 v14, v14, v38, v40
  v_or3_b32 v14, v14, v42, v44
  v_or3_b32 v14, v14, v46, v48
  v_or3_b32 v14, v14, v50, v52
  v_or3_b32 v14, v14, v54, v56
  v_or3_b32 v14, v14, v58, v60
  v_or_b32 v14, v14, v62
  v_and_b32 v14, 0xff, v14
  v_cmp_ne_u32 vcc, 0, v14
  s_add_u32 s33, s33, 1
  s_cmp_gt_u32 s33, 400000
  s_cbranch_scc1 L_fok0
  s_cbranch_vccz L_fok0
  global_load_dwordx4 v[32:35], v16, s[26:27] sc1
  global_load_dwordx4 v[36:39], v17, s[26:27] sc1
  global_load_dwordx4 v[40:43], v18, s[26:27] sc1
  global_load_dwordx4 v[44:47], v19, s[26:27] sc1
  global_load_dwordx4 v[48:51], v20, s[26:27] sc1
  global_load_dwordx4 v[52:55], v21, s[26:27] sc1
  global_load_dwordx4 v[56:59], v22, s[26:27] sc1
  global_load_dwordx4 v[60:63], v23, s[26:27] sc1
  s_branch L_fpoll
L_fok0:
  v_pk_add_f32 v[144:145], v[32:33], v[36:37]
  v_pk_add_f32 v[146:147], v[34:35], v[38:39]
  v_pk_add_f32 v[148:149], v[40:41], v[44:45]
  v_pk_add_f32 v[150:151], v[42:43], v[46:47]
  v_pk_add_f32 v[152:153], v[48:49], v[52:53]
  v_pk_add_f32 v[154:155], v[50:51], v[54:55]
  v_pk_add_f32 v[156:157], v[56:57], v[60:61]
  v_pk_add_f32 v[158:159], v[58:59], v[62:63]
L_fsum:
  v_pk_add_f32 v[144:145], v[144:145], v[148:149]
  v_pk_add_f32 v[152:153], v[152:153], v[156:157]
  v_pk_add_f32 v[146:147], v[146:147], v[150:151]
  v_pk_add_f32 v[154:155], v[154:155], v[158:159]
  v_pk_add_f32 v[160:161], v[144:145], v[152:153]
  v_pk_add_f32 v[162:163], v[146:147], v[154:155]
  s_nop 1
  v_permlane16_swap_b32 v160, v161
  v_permlane16_swap_b32 v162, v163
  v_add_f32 v160, v160, v161
  v_add_f32 v162, v162, v163
  s_nop 1
  v_permlane32_swap_b32 v160, v162
  v_add_f32 v160, v160, v162
  s_nop 1
  v_add_f32_dpp v160, v160, v160 row_shr:4 row_mask:0xf bank_mask:0xf
  s_nop 1
  v_add_f32_dpp v160, v160, v160 row_shr:8 row_mask:0xf bank_mask:0xf
  s_mov_b64 exec, s[56:57]
  v_cvt_pk_bf16_f32 v160, v160, v160
  global_store_short v28, v160, s[22:23] sc1
  s_cmp_lg_u32 s37, 0
  s_cbranch_scc1 L_noE
  s_mov_b64 exec, 1
  global_store_dword v29, v4, s[26:27] sc1
L_noE:
  s_mov_b64 exec, -1

  s_endpgm
L_aux_w:
  s_lshl_b32 s38, s28, 4
  s_add_u32 s38, s38, s29
  v_lshrrev_b32 v85, 3, v5
  v_bfe_u32 v86, v5, 2, 1
  v_lshl_add_u32 v85, v85, 1, v86
  v_mul_u32_u24 v85, 7168, v85
  v_and_b32 v87, 3, v5
  v_lshl_add_u32 v85, v87, 4, v85
  s_lshl_b32 s42, s38, 6
  s_add_u32 s42, s42, 135168
  v_add_u32 v85, s42, v85
  v_readlane_b32 s42, v82, 0
  v_readlane_b32 s43, v82, 1
  v_cmp_eq_u32 vcc, 0, v86
  s_nop 0
  v_mov_b32 v36, s43
  v_mov_b32 v37, s42
  v_cndmask_b32 v83, v36, v37, vcc
  v_lshlrev_b32 v84, 5, v86
  v_lshl_add_u32 v84, v87, 3, v84
  v_add_u32 v84, 120064, v84

  v_mov_b32 v32, 0
  v_mov_b32 v33, 0
  v_mov_b32 v34, 0
  v_mov_b32 v35, 0
  s_mov_b32 s56, -1
  s_mov_b32 s57, 0x00ffffff
  s_mov_b32 s33, 0
  s_setprio 3

  s_barrier
  s_cmp_ge_u32 s38, 112
  s_cbranch_scc1 L_hskip
  s_mov_b64 exec, s[56:57]
  global_load_dwordx4 v[32:35], v85, s[26:27] sc1
  s_mov_b64 exec, -1
L_hskip:

  s_barrier
  s_barrier
  s_barrier

  s_cmp_ge_u32 s38, 112
  s_cbranch_scc1 L_hdone
  s_mov_b64 exec, s[56:57]
  s_waitcnt vmcnt(0)
  s_branch L_hchk
L_hpoll:
  global_load_dwordx4 v[32:35], v85, s[26:27] sc1
  s_waitcnt vmcnt(0)
L_hchk:

  v_xor_b32 v32, s31, v32
  v_xor_b32 v33, s31, v33
  v_xor_b32 v34, s31, v34
  v_xor_b32 v35, s31, v35
  v_or3_b32 v40, v32, v33, v34
  v_or_b32 v40, v40, v35
  v_and_b32 v40, 0xff, v40
  v_cmp_ne_u32 vcc, 0, v40
  s_add_u32 s33, s33, 1
  s_cmp_gt_u32 s33, 400000
  s_cbranch_scc1 L_hok
  s_cbranch_vccnz L_hpoll
L_hok:
  s_mov_b64 exec, -1
  s_nop 1
  v_add_f32_dpp v32, v32, v32 row_ror:8 row_mask:0xf bank_mask:0xf
  v_add_f32_dpp v33, v33, v33 row_ror:8 row_mask:0xf bank_mask:0xf
  v_add_f32_dpp v34, v34, v34 row_ror:8 row_mask:0xf bank_mask:0xf
  v_add_f32_dpp v35, v35, v35 row_ror:8 row_mask:0xf bank_mask:0xf
  v_mov_b32 v36, v32
  v_mov_b32 v37, v33
  v_mov_b32 v38, v34
  v_mov_b32 v39, v35
  s_nop 1
  v_permlane16_swap_b32 v32, v36
  v_permlane16_swap_b32 v33, v37
  v_permlane16_swap_b32 v34, v38
  v_permlane16_swap_b32 v35, v39
  v_add_f32 v32, v32, v36
  v_add_f32 v33, v33, v37
  v_add_f32 v34, v34, v38
  v_add_f32 v35, v35, v39
  v_mov_b32 v36, v32
  v_mov_b32 v37, v33
  v_mov_b32 v38, v34
  v_mov_b32 v39, v35
  s_nop 1
  v_permlane32_swap_b32 v32, v36
  v_permlane32_swap_b32 v33, v37
  v_permlane32_swap_b32 v34, v38
  v_permlane32_swap_b32 v35, v39
  v_add_f32 v32, v32, v36
  v_add_f32 v33, v33, v37
  v_add_f32 v34, v34, v38
  v_add_f32 v35, v35, v39
L_hdone:
  v_max_f32 v32, 0, v32
  v_mul_f32 v32, v32, v83
  v_max_f32 v33, 0, v33
  v_mul_f32 v33, v33, v83
  v_max_f32 v34, 0, v34
  v_mul_f32 v34, v34, v83
  v_max_f32 v35, 0, v35
  v_mul_f32 v35, v35, v83
  v_cvt_pk_bf16_f32 v32, v32, v33
  v_cvt_pk_bf16_f32 v33, v34, v35
  s_mov_b64 exec, 0xff
  ds_write_b64 v84, v[32:33]
  s_mov_b64 exec, -1
  s_waitcnt lgkmcnt(0)

  s_barrier
L_end:
  s_endpgm
L_code_end:
.section .rodata,"a"
.p2align 6
.amdhsa_kernel gated_mix__sliding_block_cached__dense_activation_relu__decode_kernel
  .amdhsa_next_free_vgpr 240
  .amdhsa_next_free_sgpr 100
  .amdhsa_accum_offset 240
  .amdhsa_group_segment_fixed_size 0
  .amdhsa_kernarg_size 96
  .amdhsa_user_sgpr_count 2
  .amdhsa_user_sgpr_kernarg_segment_ptr 1
  .amdhsa_system_sgpr_workgroup_id_x 1
.end_amdhsa_kernel
```
